```python
import torch

def _softmax(x, axis=-1):
    return torch.softmax(x, dim=axis)
def _gelu(x):
    return torch.nn.functional.gelu(x, approximate="tanh")
def _silu(x):
    return torch.nn.functional.silu(x)
def _sigmoid(x):
    return torch.sigmoid(x)
def _layernorm(x, axis=-1, eps=1e-5):
    m = x.mean(dim=axis, keepdim=True)
    v = x.var(dim=axis, keepdim=True, unbiased=False)
    return (x - m) / torch.sqrt(v + eps)
def _scatter_add(tgt, idx, src, axis=0):
    return tgt.clone().index_add_(axis, idx, src)
def _segment_sum(src, seg, n):
    out = torch.zeros((n,) + src.shape[1:], dtype=src.dtype)
    return out.index_add_(0, seg, src)
def _pad(x, pw):
    flat = tuple(v for pair in reversed(pw) for v in pair)
    return torch.nn.functional.pad(x, flat)

kernel_name = 'standalone__w4a16_gemm_dequant__prompt'

def setup_inputs():

    _w = (lambda a: (lambda t: t.to(torch.bfloat16) if t.is_floating_point() else t)(torch.as_tensor(a)))
    B, S, D, F = 1, 2048, 1024, 3584
    G = 32 if 32 > 0 else D
    D = (D // G) * G
    ng = D // G
    qw = torch.randint(0, 16, (D, F)).to(torch.int32)
    return {
        "x": _w((lambda *s: torch.randn(*s, dtype=torch.bfloat16) * 0.05)(B, S, D)),
        "qw": _w(qw),
        "scales": _w(torch.abs((lambda *s: torch.randn(*s, dtype=torch.bfloat16) * 0.05)(ng, F)) + 0.01),
        "zeros": _w(torch.full((ng, F), 8.0, dtype=float)),
    }

def reference(x, qw, scales, zeros):
    B, S, D = x.shape
    ng, F = scales.shape
    G = D // ng
    s = (lambda x, n, axis: torch.repeat_interleave(x, n, dim=axis))(scales, G, axis=0)
    z = (lambda x, n, axis: torch.repeat_interleave(x, n, dim=axis))(zeros, G, axis=0)
    w = ((lambda x, dt: x.to(dt))(qw, x.dtype) - z) * s
    return x @ w
```

```asm
; @launch grid=(224,1,1) block=(512,1,1) lds=163840
.amdgcn_target "amdgcn-amd-amdhsa--gfx950"
.text
.globl standalone__w4a16_gemm_dequant__prompt_kernel
.p2align 12

.p2align 8
.type standalone__w4a16_gemm_dequant__prompt_kernel,@function
standalone__w4a16_gemm_dequant__prompt_kernel:
    s_load_dwordx2 s[8:9], s[0:1], 8
    s_load_dwordx2 s[12:13], s[0:1], 16
    s_load_dwordx2 s[16:17], s[0:1], 24
    s_load_dwordx2 s[4:5], s[0:1], 0
    s_load_dwordx2 s[20:21], s[0:1], 32
    v_lshrrev_b32 v1, 6, v0
    v_and_b32 v0, 63, v0
    v_readfirstlane_b32 s24, v1
    s_cmpk_ge_u32 s2, 224
    s_cbranch_scc1 L_end
    s_bfe_u32 s35, s2, 0x20001
    s_lshr_b32 s28, s2, 5
    s_mul_i32 s27, s35, 7
    s_add_u32 s27, s27, s28
    s_and_b32 s36, s2, 1
    s_xor_b32 s39, s35, s36
    s_bfe_u32 s35, s2, 0x20003
    s_lshl2_add_u32 s26, s36, s35
    s_add_u32 s38, s35, s28
    s_mov_b32 s14, 229376
    s_mov_b32 s15, 0x20000
    s_mov_b64 s[18:19], s[14:15]
    s_and_b32 s25, s24, 3
    s_lshl2_add_u32 s26, s26, s25
    s_lshl_b32 s26, s26, 6
    s_cmp_ge_u32 s24, 4
    s_cbranch_scc1 L_consumer
    v_and_b32 v22, 31, v0
    v_lshrrev_b32 v23, 5, v0
    s_lshl_b32 s39, s39, 1
    s_and_b32 s37, s38, 1
    s_xor_b32 s37, s37, s39
    s_bfe_u32 s40, s38, 0x10001
    v_lshl_add_u32 v1, s25, 1, v23
    v_mul_u32_u24 v1, 114688, v1
    s_lshl_b32 s35, s27, 5
    v_add_u32 v18, s35, v22
    v_lshl_add_u32 v2, v18, 4, v1
    v_lshlrev_b32 v18, 3, v18
    s_movk_i32 s36, 14336
    v_add_u32 v3, s36, v2
    v_add_u32 v4, s36, v3
    v_add_u32 v5, s36, v4
    s_lshl4_add_u32 s35, s37, s40
    s_mul_i32 s29, s35, 57344
    s_lshr_b32 s34, s25, 1
    s_lshl1_add_u32 s31, s37, s34
    s_mulk_i32 s31, 7168
    s_mov_b32 s10, 14680064
    s_mov_b32 s11, s15
    s_waitcnt lgkmcnt(0)
    buffer_load_dwordx2 v[40:41], v18, s[12:15], s31 offen
    buffer_load_dwordx2 v[42:43], v18, s[16:19], s31 offen
    buffer_load_dwordx4 v[96:99], v2, s[8:11], s29 offen
    buffer_load_dwordx4 v[100:103], v3, s[8:11], s29 offen
    buffer_load_dwordx4 v[104:107], v4, s[8:11], s29 offen
    buffer_load_dwordx4 v[108:111], v5, s[8:11], s29 offen
    v_lshrrev_b32 v1, 3, v0
    v_add_lshl_u32 v1, v1, s26, 11
    v_lshrrev_b32 v24, 4, v0
    v_and_b32 v25, 7, v0
    v_xor_b32 v24, v24, v25
    v_lshl_add_u32 v10, v24, 4, v1
    v_xor_b32 v1, 64, v10
    v_add_u32 v11, 15360, v1
    v_add_u32 v12, 30720, v10
    v_add_u32 v13, 46080, v1
    s_mov_b32 s6, 4194304
    s_mov_b32 s7, s15
    s_lshl_b32 s32, s25, 13
    s_lshl_b32 s30, s37, 7
    s_lshl_b32 s35, s40, 12
    s_add_u32 s31, s32, s35
    s_mov_b32 m0, s31
    s_lshl4_add_u32 s30, s35, s30
    buffer_load_dwordx4 v10, s[4:7], s30 offen lds
    buffer_load_dwordx4 v11, s[4:7], s30 offen offset:1024 lds
    buffer_load_dwordx4 v12, s[4:7], s30 offen offset:2048 lds
    buffer_load_dwordx4 v13, s[4:7], s30 offen offset:3072 lds
    s_branch L_prod2
L_consumer:
    s_setprio 1
    v_mov_b32 v231, v0
    v_lshrrev_b32 v2, 4, v0
    v_lshl_add_u32 v1, s25, 3, v2
    v_and_b32 v3, 15, v0
    v_mul_u32_u24 v4, 7168, v1
    s_lshl_b32 s35, s27, 4
    v_add_lshl_u32 v5, v3, s35, 4
    v_add_u32 v177, v4, v5
    s_movk_i32 s36, 28672
    s_waitcnt lgkmcnt(0)
    buffer_load_dwordx4 v[128:131], v177, s[12:15], 0 offen
    buffer_load_dwordx4 v[132:135], v177, s[16:19], 0 offen
    buffer_load_dwordx4 v[136:139], v177, s[12:15], s36 offen
    buffer_load_dwordx4 v[140:143], v177, s[16:19], s36 offen
    s_getpc_b64 s[44:45]
L_pc1:
    s_lshr_b32 s35, s2, 3
    s_lshl2_add_u32 s35, s35, s25
    s_lshl_b32 s35, s35, 7
    s_min_u32 s35, s35, L_end-L_pc1-64
    s_load_dword s46, s[44:45], s35
    s_add_u32 s35, s35, 64
    s_load_dword s47, s[44:45], s35
    v_lshlrev_b32 v4, 9, v1
    v_lshl_add_u32 v4, v3, 5, v4
    v_add_u32 v176, 131072, v4
    s_mov_b32 s22, 14680064
    s_mov_b32 s23, s15
    v_lshrrev_b32 v4, 1, v3
    v_xor_b32 v4, v4, v2
    v_lshlrev_b32 v4, 4, v4
    v_lshl_add_u32 v4, v3, 7, v4
    v_lshl_add_u32 v226, s25, 13, v4
    v_xor_b32 v227, 64, v226
    v_mov_b64 v[224:225], v[226:227]
    v_lshlrev_b32 v4, 4, v0
    v_add_u32 v228, 98304, v4
    v_xor_b32 v229, 64, v228
    v_lshl_add_u32 v4, v2, 2, s26
    v_mul_u32_u24 v4, 7168, v4
    v_add_u32 v230, v4, v5
    v_mov_b64 v[0:1], 0
    v_mov_b64 v[2:3], 0
    v_mov_b64 v[4:5], 0
    v_mov_b64 v[6:7], 0
    v_mov_b64 v[8:9], 0
    v_mov_b64 v[10:11], 0
    v_mov_b64 v[12:13], 0
    v_mov_b64 v[14:15], 0
    v_mov_b64 v[16:17], 0
    v_mov_b64 v[18:19], 0
    v_mov_b64 v[20:21], 0
    v_mov_b64 v[22:23], 0
    v_mov_b64 v[24:25], 0
    v_mov_b64 v[26:27], 0
    v_mov_b64 v[28:29], 0
    v_mov_b64 v[30:31], 0
    v_mov_b64 v[32:33], 0
    v_mov_b64 v[34:35], 0
    v_mov_b64 v[36:37], 0
    v_mov_b64 v[38:39], 0
    v_mov_b64 v[40:41], 0
    v_mov_b64 v[42:43], 0
    v_mov_b64 v[44:45], 0
    v_mov_b64 v[46:47], 0
    v_mov_b64 v[48:49], 0
    v_mov_b64 v[50:51], 0
    v_mov_b64 v[52:53], 0
    v_mov_b64 v[54:55], 0
    v_mov_b64 v[56:57], 0
    v_mov_b64 v[58:59], 0
    v_mov_b64 v[60:61], 0
    v_mov_b64 v[62:63], 0
    v_mov_b64 v[64:65], 0
    v_mov_b64 v[66:67], 0
    v_mov_b64 v[68:69], 0
    v_mov_b64 v[70:71], 0
    v_mov_b64 v[72:73], 0
    v_mov_b64 v[74:75], 0
    v_mov_b64 v[76:77], 0
    v_mov_b64 v[78:79], 0
    v_mov_b64 v[80:81], 0
    v_mov_b64 v[82:83], 0
    v_mov_b64 v[84:85], 0
    v_mov_b64 v[86:87], 0
    v_mov_b64 v[88:89], 0
    v_mov_b64 v[90:91], 0
    v_mov_b64 v[92:93], 0
    v_mov_b64 v[94:95], 0
    v_mov_b64 v[96:97], 0
    v_mov_b64 v[98:99], 0
    v_mov_b64 v[100:101], 0
    v_mov_b64 v[102:103], 0
    v_mov_b64 v[104:105], 0
    v_mov_b64 v[106:107], 0
    v_mov_b64 v[108:109], 0
    v_mov_b64 v[110:111], 0
    v_mov_b64 v[112:113], 0
    v_mov_b64 v[114:115], 0
    v_mov_b64 v[116:117], 0
    v_mov_b64 v[118:119], 0
    v_mov_b64 v[120:121], 0
    v_mov_b64 v[122:123], 0
    v_mov_b64 v[124:125], 0
    v_mov_b64 v[126:127], 0
    s_waitcnt vmcnt(2)
    v_lshlrev_b32 v144, 16, v128
    v_and_b32 v145, 0xffff0000, v128
    v_lshlrev_b32 v180, 16, v132
    v_and_b32 v181, 0xffff0000, v132
    v_lshlrev_b32 v146, 16, v129
    v_and_b32 v147, 0xffff0000, v129
    v_lshlrev_b32 v182, 16, v133
    v_and_b32 v183, 0xffff0000, v133
    v_mul_f32_e64 v152, -v180, v144
    v_mul_f32_e64 v153, -v181, v145
    v_mul_f32_e64 v154, -v182, v146
    v_mul_f32_e64 v155, -v183, v147
    v_mul_f32 v144, 0x4b800000, v144
    v_mul_f32 v145, 0x4b800000, v145
    v_mul_f32 v146, 0x4b800000, v146
    v_mul_f32 v147, 0x4b800000, v147
    v_lshlrev_b32 v148, 16, v130
    v_and_b32 v149, 0xffff0000, v130
    v_lshlrev_b32 v180, 16, v134
    v_and_b32 v181, 0xffff0000, v134
    v_lshlrev_b32 v150, 16, v131
    v_and_b32 v151, 0xffff0000, v131
    v_lshlrev_b32 v182, 16, v135
    v_and_b32 v183, 0xffff0000, v135
    v_mul_f32_e64 v156, -v180, v148
    v_mul_f32_e64 v157, -v181, v149
    v_mul_f32_e64 v158, -v182, v150
    v_mul_f32_e64 v159, -v183, v151
    v_mul_f32 v148, 0x4b800000, v148
    v_mul_f32 v149, 0x4b800000, v149
    v_mul_f32 v150, 0x4b800000, v150
    v_mul_f32 v151, 0x4b800000, v151
    ds_write_b128 v176, v[144:147] offset:0
    ds_write_b128 v176, v[152:155] offset:16384
    ds_write_b128 v176, v[148:151] offset:16
    ds_write_b128 v176, v[156:159] offset:16400
    s_waitcnt vmcnt(0)
    v_lshlrev_b32 v160, 16, v136
    v_and_b32 v161, 0xffff0000, v136
    v_lshlrev_b32 v180, 16, v140
    v_and_b32 v181, 0xffff0000, v140
    v_lshlrev_b32 v162, 16, v137
    v_and_b32 v163, 0xffff0000, v137
    v_lshlrev_b32 v182, 16, v141
    v_and_b32 v183, 0xffff0000, v141
    v_mul_f32_e64 v168, -v180, v160
    v_mul_f32_e64 v169, -v181, v161
    v_mul_f32_e64 v170, -v182, v162
    v_mul_f32_e64 v171, -v183, v163
    v_mul_f32 v160, 0x4b800000, v160
    v_mul_f32 v161, 0x4b800000, v161
    v_mul_f32 v162, 0x4b800000, v162
    v_mul_f32 v163, 0x4b800000, v163
    v_lshlrev_b32 v164, 16, v138
    v_and_b32 v165, 0xffff0000, v138
    v_lshlrev_b32 v180, 16, v142
    v_and_b32 v181, 0xffff0000, v142
    v_lshlrev_b32 v166, 16, v139
    v_and_b32 v167, 0xffff0000, v139
    v_lshlrev_b32 v182, 16, v143
    v_and_b32 v183, 0xffff0000, v143
    v_mul_f32_e64 v172, -v180, v164
    v_mul_f32_e64 v173, -v181, v165
    v_mul_f32_e64 v174, -v182, v166
    v_mul_f32_e64 v175, -v183, v167
    v_mul_f32 v164, 0x4b800000, v164
    v_mul_f32 v165, 0x4b800000, v165
    v_mul_f32 v166, 0x4b800000, v166
    v_mul_f32 v167, 0x4b800000, v167
    ds_write_b128 v176, v[160:163] offset:2048
    ds_write_b128 v176, v[168:171] offset:18432
    ds_write_b128 v176, v[164:167] offset:2064
    ds_write_b128 v176, v[172:175] offset:18448
    s_movk_i32 s34, 6
    s_mov_b32 s31, 32768
    s_branch L_consumer2
L_prod2:
    v_add_u32 v6, s36, v5
    v_add_u32 v7, s36, v6
    v_add_u32 v8, s36, v7
    v_add_u32 v9, s36, v8
    v_add_u32 v14, 0x10000, v10
    v_add_u32 v15, 0x10000, v11
    v_add_u32 v16, 0x10000, v12
    v_add_u32 v17, 0x10000, v13
    s_and_b32 s38, s38, 3
    s_mov_b32 s42, 0xa7546312
    s_mov_b32 s43, 0xfdceb98
    s_cmp_eq_u32 s38, 1
    s_cselect_b32 s42, 0x86574203, s42
    s_cselect_b32 s43, 0xedfca9b, s43
    s_cmp_eq_u32 s38, 2
    s_cselect_b32 s42, 0x76853241, s42
    s_cselect_b32 s43, 0xfedbac9, s43
    s_cmp_eq_u32 s38, 3
    s_cselect_b32 s42, 0x79643250, s42
    s_cselect_b32 s43, 0xfecbda8, s43
    s_mul_i32 s35, s39, 0x11111111
    s_xor_b32 s42, s42, s35
    s_xor_b32 s43, s43, s35
    s_add_u32 s33, s32, 98304
    s_lshl_b32 s35, s34, 9
    s_add_u32 s35, s35, 131072
    v_lshl_add_u32 v21, v22, 4, s35
    s_and_b32 s35, s25, 1
    v_lshl_add_u32 v1, s35, 1, v23
    v_lshrrev_b32 v24, 1, v22
    v_lshl_add_u32 v1, v1, 4, v24
    v_and_b32 v24, 1, v22
    v_mul_u32_u24 v24, 0x104, v24
    v_xor_b32 v1, v1, v24
    s_lshl_b32 s35, s34, 13
    s_add_u32 s35, s35, 98304
    v_lshl_add_u32 v19, v1, 4, s35
    v_lshl_add_u32 v44, s40, 3, v19
    v_xor_b32 v45, 8, v44
    s_lshl4_add_u32 s35, s37, s40
    s_xor_b32 s35, s35, 1
    s_mul_i32 s29, s35, 57344
    s_xor_b32 m0, s31, 0x1000
    s_xor_b32 s30, s30, 0x10000
    buffer_load_dwordx4 v[112:115], v2, s[8:11], s29 offen
    buffer_load_dwordx4 v[116:119], v3, s[8:11], s29 offen
    buffer_load_dwordx4 v[120:123], v4, s[8:11], s29 offen
    buffer_load_dwordx4 v[124:127], v5, s[8:11], s29 offen
    buffer_load_dwordx4 v10, s[4:7], s30 offen lds
    buffer_load_dwordx4 v11, s[4:7], s30 offen offset:1024 lds
    buffer_load_dwordx4 v12, s[4:7], s30 offen offset:2048 lds
    buffer_load_dwordx4 v13, s[4:7], s30 offen offset:3072 lds
    s_mov_b32 s31, s32
    s_and_b32 s37, s42, 15
    s_mul_i32 s29, s37, 917504
    s_lshl_b32 s30, s37, 7
    s_add_u32 s31, s31, 32768
    s_cmp_eq_u32 s31, s33
    s_cselect_b32 s31, s32, s31
    v_lshl_add_u32 v20, s37, 10, v21
    s_waitcnt vmcnt(16)
    v_lshlrev_b32 v32, 16, v40
    v_and_b32 v33, 0xffff0000, v40
    v_lshlrev_b32 v24, 16, v42
    v_and_b32 v25, 0xffff0000, v42
    v_lshlrev_b32 v34, 16, v41
    v_and_b32 v35, 0xffff0000, v41
    v_lshlrev_b32 v26, 16, v43
    v_and_b32 v27, 0xffff0000, v43
    v_mul_f32_e64 v36, -v24, v32
    v_mul_f32_e64 v37, -v25, v33
    v_mul_f32_e64 v38, -v26, v34
    v_mul_f32_e64 v39, -v27, v35
    v_mul_f32 v32, 0x4b800000, v32
    v_mul_f32 v33, 0x4b800000, v33
    v_mul_f32 v34, 0x4b800000, v34
    v_mul_f32 v35, 0x4b800000, v35
    s_waitcnt vmcnt(12)
    v_fma_mix_f32 v24, v96, v32, v36 op_sel_hi:[1,0,0]
    v_fma_mix_f32 v25, v97, v33, v37 op_sel_hi:[1,0,0]
    v_fma_mix_f32 v26, v98, v34, v38 op_sel_hi:[1,0,0]
    v_fma_mix_f32 v27, v99, v35, v39 op_sel_hi:[1,0,0]
    v_fma_mix_f32 v28, v100, v32, v36 op_sel_hi:[1,0,0]
    v_fma_mix_f32 v29, v101, v33, v37 op_sel_hi:[1,0,0]
    v_fma_mix_f32 v30, v102, v34, v38 op_sel_hi:[1,0,0]
    v_fma_mix_f32 v31, v103, v35, v39 op_sel_hi:[1,0,0]
    v_cvt_pk_bf16_f32 v48, v24, v28
    v_cvt_pk_bf16_f32 v52, v25, v29
    v_cvt_pk_bf16_f32 v56, v26, v30
    v_cvt_pk_bf16_f32 v60, v27, v31
    buffer_load_dwordx4 v[64:67], v2, s[8:11], s29 offen
    v_fma_mix_f32 v24, v104, v32, v36 op_sel_hi:[1,0,0]
    v_fma_mix_f32 v25, v105, v33, v37 op_sel_hi:[1,0,0]
    v_fma_mix_f32 v26, v106, v34, v38 op_sel_hi:[1,0,0]
    v_fma_mix_f32 v27, v107, v35, v39 op_sel_hi:[1,0,0]
    v_fma_mix_f32 v28, v108, v32, v36 op_sel_hi:[1,0,0]
    v_fma_mix_f32 v29, v109, v33, v37 op_sel_hi:[1,0,0]
    v_fma_mix_f32 v30, v110, v34, v38 op_sel_hi:[1,0,0]
    v_fma_mix_f32 v31, v111, v35, v39 op_sel_hi:[1,0,0]
    v_cvt_pk_bf16_f32 v49, v24, v28
    v_cvt_pk_bf16_f32 v53, v25, v29
    v_cvt_pk_bf16_f32 v57, v26, v30
    v_cvt_pk_bf16_f32 v61, v27, v31
    ds_write_b64 v44, v[48:49]
    ds_write_b64 v44, v[52:53] offset:1024
    ds_write_b64 v44, v[56:57] offset:2048
    ds_write_b64 v44, v[60:61] offset:3072
    buffer_load_dwordx4 v[68:71], v3, s[8:11], s29 offen
    buffer_load_dwordx4 v[72:75], v4, s[8:11], s29 offen
    buffer_load_dwordx4 v[76:79], v5, s[8:11], s29 offen
    s_waitcnt vmcnt(8)
    v_fma_mix_f32 v24, v112, v32, v36 op_sel_hi:[1,0,0]
    v_fma_mix_f32 v25, v113, v33, v37 op_sel_hi:[1,0,0]
    v_fma_mix_f32 v26, v114, v34, v38 op_sel_hi:[1,0,0]
    v_fma_mix_f32 v27, v115, v35, v39 op_sel_hi:[1,0,0]
    v_fma_mix_f32 v28, v116, v32, v36 op_sel_hi:[1,0,0]
    v_fma_mix_f32 v29, v117, v33, v37 op_sel_hi:[1,0,0]
    v_fma_mix_f32 v30, v118, v34, v38 op_sel_hi:[1,0,0]
    v_fma_mix_f32 v31, v119, v35, v39 op_sel_hi:[1,0,0]
    v_cvt_pk_bf16_f32 v50, v24, v28
    v_cvt_pk_bf16_f32 v54, v25, v29
    v_cvt_pk_bf16_f32 v58, v26, v30
    v_cvt_pk_bf16_f32 v62, v27, v31
    buffer_load_dwordx4 v[80:83], v6, s[8:11], s29 offen
    v_fma_mix_f32 v24, v120, v32, v36 op_sel_hi:[1,0,0]
    v_fma_mix_f32 v25, v121, v33, v37 op_sel_hi:[1,0,0]
    v_fma_mix_f32 v26, v122, v34, v38 op_sel_hi:[1,0,0]
    v_fma_mix_f32 v27, v123, v35, v39 op_sel_hi:[1,0,0]
    v_fma_mix_f32 v28, v124, v32, v36 op_sel_hi:[1,0,0]
    v_fma_mix_f32 v29, v125, v33, v37 op_sel_hi:[1,0,0]
    v_fma_mix_f32 v30, v126, v34, v38 op_sel_hi:[1,0,0]
    v_fma_mix_f32 v31, v127, v35, v39 op_sel_hi:[1,0,0]
    v_cvt_pk_bf16_f32 v51, v24, v28
    v_cvt_pk_bf16_f32 v55, v25, v29
    v_cvt_pk_bf16_f32 v59, v26, v30
    v_cvt_pk_bf16_f32 v63, v27, v31
    ds_write_b64 v45, v[50:51]
    ds_write_b64 v45, v[54:55] offset:1024
    ds_write_b64 v45, v[58:59] offset:2048
    ds_write_b64 v45, v[62:63] offset:3072
    buffer_load_dwordx4 v[84:87], v7, s[8:11], s29 offen
    buffer_load_dwordx4 v[88:91], v8, s[8:11], s29 offen
    buffer_load_dwordx4 v[92:95], v9, s[8:11], s29 offen
    s_movk_i32 s34, 6
    s_waitcnt vmcnt(8) lgkmcnt(0)
    s_barrier
    s_mov_b32 m0, s31
    s_nop 0
    buffer_load_dwordx4 v10, s[4:7], s30 offen lds
    buffer_load_dwordx4 v11, s[4:7], s30 offen offset:1024 lds
    buffer_load_dwordx4 v12, s[4:7], s30 offen offset:2048 lds
    .p2align 3
L_ploop:
    buffer_load_dwordx4 v13, s[4:7], s30 offen offset:3072 lds
    s_add_u32 m0, s31, 4096
    ds_read_b128 v[32:35], v20
    ds_read_b128 v[36:39], v20 offset:16384
    s_bfe_u32 s37, s42, 0x40004
    s_mul_i32 s29, s37, 917504
    buffer_load_dwordx4 v14, s[4:7], s30 offen lds
    s_waitcnt vmcnt(11) lgkmcnt(0)
    v_fma_mix_f32 v24, v64, v32, v36 op_sel_hi:[1,0,0]
    v_fma_mix_f32 v25, v65, v33, v37 op_sel_hi:[1,0,0]
    v_fma_mix_f32 v26, v66, v34, v38 op_sel_hi:[1,0,0]
    v_fma_mix_f32 v27, v67, v35, v39 op_sel_hi:[1,0,0]
    v_fma_mix_f32 v28, v68, v32, v36 op_sel_hi:[1,0,0]
    v_fma_mix_f32 v29, v69, v33, v37 op_sel_hi:[1,0,0]
    buffer_load_dwordx4 v15, s[4:7], s30 offen offset:1024 lds
    v_fma_mix_f32 v30, v70, v34, v38 op_sel_hi:[1,0,0]
    v_fma_mix_f32 v31, v71, v35, v39 op_sel_hi:[1,0,0]
    v_cvt_pk_bf16_f32 v48, v24, v28
    v_cvt_pk_bf16_f32 v52, v25, v29
    v_cvt_pk_bf16_f32 v56, v26, v30
    buffer_load_dwordx4 v16, s[4:7], s30 offen offset:2048 lds
    v_cvt_pk_bf16_f32 v60, v27, v31
    s_waitcnt vmcnt(11)
    v_fma_mix_f32 v24, v72, v32, v36 op_sel_hi:[1,0,0]
    v_fma_mix_f32 v25, v73, v33, v37 op_sel_hi:[1,0,0]
    v_fma_mix_f32 v26, v74, v34, v38 op_sel_hi:[1,0,0]
    v_fma_mix_f32 v27, v75, v35, v39 op_sel_hi:[1,0,0]
    buffer_load_dwordx4 v17, s[4:7], s30 offen offset:3072 lds
    v_fma_mix_f32 v28, v76, v32, v36 op_sel_hi:[1,0,0]
    v_fma_mix_f32 v29, v77, v33, v37 op_sel_hi:[1,0,0]
    v_fma_mix_f32 v30, v78, v34, v38 op_sel_hi:[1,0,0]
    v_fma_mix_f32 v31, v79, v35, v39 op_sel_hi:[1,0,0]
    v_cvt_pk_bf16_f32 v49, v24, v28
    v_cvt_pk_bf16_f32 v53, v25, v29
    buffer_load_dwordx4 v[64:67], v2, s[8:11], s29 offen
    v_cvt_pk_bf16_f32 v57, v26, v30
    v_cvt_pk_bf16_f32 v61, v27, v31
    s_waitcnt vmcnt(11)
    v_fma_mix_f32 v24, v80, v32, v36 op_sel_hi:[1,0,0]
    v_fma_mix_f32 v25, v81, v33, v37 op_sel_hi:[1,0,0]
    v_fma_mix_f32 v26, v82, v34, v38 op_sel_hi:[1,0,0]
    buffer_load_dwordx4 v[68:71], v3, s[8:11], s29 offen
    v_fma_mix_f32 v27, v83, v35, v39 op_sel_hi:[1,0,0]
    v_fma_mix_f32 v28, v84, v32, v36 op_sel_hi:[1,0,0]
    v_fma_mix_f32 v29, v85, v33, v37 op_sel_hi:[1,0,0]
    v_fma_mix_f32 v30, v86, v34, v38 op_sel_hi:[1,0,0]
    v_fma_mix_f32 v31, v87, v35, v39 op_sel_hi:[1,0,0]
    buffer_load_dwordx4 v[72:75], v4, s[8:11], s29 offen
    v_cvt_pk_bf16_f32 v50, v24, v28
    v_cvt_pk_bf16_f32 v54, v25, v29
    v_cvt_pk_bf16_f32 v58, v26, v30
    v_cvt_pk_bf16_f32 v62, v27, v31
    s_waitcnt vmcnt(11)
    v_fma_mix_f32 v24, v88, v32, v36 op_sel_hi:[1,0,0]
    v_fma_mix_f32 v25, v89, v33, v37 op_sel_hi:[1,0,0]
    buffer_load_dwordx4 v[76:79], v5, s[8:11], s29 offen
    v_fma_mix_f32 v26, v90, v34, v38 op_sel_hi:[1,0,0]
    v_fma_mix_f32 v27, v91, v35, v39 op_sel_hi:[1,0,0]
    v_fma_mix_f32 v28, v92, v32, v36 op_sel_hi:[1,0,0]
    v_fma_mix_f32 v29, v93, v33, v37 op_sel_hi:[1,0,0]
    v_fma_mix_f32 v30, v94, v34, v38 op_sel_hi:[1,0,0]
    buffer_load_dwordx4 v[80:83], v6, s[8:11], s29 offen
    v_fma_mix_f32 v31, v95, v35, v39 op_sel_hi:[1,0,0]
    v_cvt_pk_bf16_f32 v51, v24, v28
    v_cvt_pk_bf16_f32 v55, v25, v29
    v_cvt_pk_bf16_f32 v59, v26, v30
    v_cvt_pk_bf16_f32 v63, v27, v31
    buffer_load_dwordx4 v[84:87], v7, s[8:11], s29 offen
    ds_write_b128 v19, v[48:51] offset:16384
    buffer_load_dwordx4 v[88:91], v8, s[8:11], s29 offen
    ds_write_b128 v19, v[52:55] offset:17408
    s_lshl_b32 s30, s37, 7
    s_add_u32 s31, s31, 32768
    s_cmp_eq_u32 s31, s33
    s_cselect_b32 s31, s32, s31
    buffer_load_dwordx4 v[92:95], v9, s[8:11], s29 offen
    s_mov_b32 m0, s31
    ds_write_b128 v19, v[56:59] offset:18432
    buffer_load_dwordx4 v10, s[4:7], s30 offen lds
    ds_write_b128 v19, v[60:63] offset:19456
    buffer_load_dwordx4 v11, s[4:7], s30 offen offset:1024 lds
    v_lshl_add_u32 v20, s37, 10, v21
    s_lshr_b64 s[42:43], s[42:43], 8
    buffer_load_dwordx4 v12, s[4:7], s30 offen offset:2048 lds
    s_sub_u32 s34, s34, 1
    s_waitcnt vmcnt(11) lgkmcnt(0)
    s_barrier
    s_cbranch_scc1 L_pexit
    buffer_load_dwordx4 v13, s[4:7], s30 offen offset:3072 lds
    s_add_u32 m0, s31, 4096
    ds_read_b128 v[32:35], v20
    ds_read_b128 v[36:39], v20 offset:16384
    s_and_b32 s37, s42, 15
    s_mul_i32 s29, s37, 917504
    buffer_load_dwordx4 v14, s[4:7], s30 offen lds
    s_waitcnt vmcnt(11) lgkmcnt(0)
    v_fma_mix_f32 v24, v64, v32, v36 op_sel_hi:[1,0,0]
    v_fma_mix_f32 v25, v65, v33, v37 op_sel_hi:[1,0,0]
    v_fma_mix_f32 v26, v66, v34, v38 op_sel_hi:[1,0,0]
    v_fma_mix_f32 v27, v67, v35, v39 op_sel_hi:[1,0,0]
    v_fma_mix_f32 v28, v68, v32, v36 op_sel_hi:[1,0,0]
    v_fma_mix_f32 v29, v69, v33, v37 op_sel_hi:[1,0,0]
    buffer_load_dwordx4 v15, s[4:7], s30 offen offset:1024 lds
    v_fma_mix_f32 v30, v70, v34, v38 op_sel_hi:[1,0,0]
    v_fma_mix_f32 v31, v71, v35, v39 op_sel_hi:[1,0,0]
    v_cvt_pk_bf16_f32 v48, v24, v28
    v_cvt_pk_bf16_f32 v52, v25, v29
    v_cvt_pk_bf16_f32 v56, v26, v30
    buffer_load_dwordx4 v16, s[4:7], s30 offen offset:2048 lds
    v_cvt_pk_bf16_f32 v60, v27, v31
    s_waitcnt vmcnt(11)
    v_fma_mix_f32 v24, v72, v32, v36 op_sel_hi:[1,0,0]
    v_fma_mix_f32 v25, v73, v33, v37 op_sel_hi:[1,0,0]
    v_fma_mix_f32 v26, v74, v34, v38 op_sel_hi:[1,0,0]
    v_fma_mix_f32 v27, v75, v35, v39 op_sel_hi:[1,0,0]
    buffer_load_dwordx4 v17, s[4:7], s30 offen offset:3072 lds
    v_fma_mix_f32 v28, v76, v32, v36 op_sel_hi:[1,0,0]
    v_fma_mix_f32 v29, v77, v33, v37 op_sel_hi:[1,0,0]
    v_fma_mix_f32 v30, v78, v34, v38 op_sel_hi:[1,0,0]
    v_fma_mix_f32 v31, v79, v35, v39 op_sel_hi:[1,0,0]
    v_cvt_pk_bf16_f32 v49, v24, v28
    v_cvt_pk_bf16_f32 v53, v25, v29
    buffer_load_dwordx4 v[64:67], v2, s[8:11], s29 offen
    v_cvt_pk_bf16_f32 v57, v26, v30
    v_cvt_pk_bf16_f32 v61, v27, v31
    s_waitcnt vmcnt(11)
    v_fma_mix_f32 v24, v80, v32, v36 op_sel_hi:[1,0,0]
    v_fma_mix_f32 v25, v81, v33, v37 op_sel_hi:[1,0,0]
    v_fma_mix_f32 v26, v82, v34, v38 op_sel_hi:[1,0,0]
    buffer_load_dwordx4 v[68:71], v3, s[8:11], s29 offen
    v_fma_mix_f32 v27, v83, v35, v39 op_sel_hi:[1,0,0]
    v_fma_mix_f32 v28, v84, v32, v36 op_sel_hi:[1,0,0]
    v_fma_mix_f32 v29, v85, v33, v37 op_sel_hi:[1,0,0]
    v_fma_mix_f32 v30, v86, v34, v38 op_sel_hi:[1,0,0]
    v_fma_mix_f32 v31, v87, v35, v39 op_sel_hi:[1,0,0]
    buffer_load_dwordx4 v[72:75], v4, s[8:11], s29 offen
    v_cvt_pk_bf16_f32 v50, v24, v28
    v_cvt_pk_bf16_f32 v54, v25, v29
    v_cvt_pk_bf16_f32 v58, v26, v30
    v_cvt_pk_bf16_f32 v62, v27, v31
    s_waitcnt vmcnt(11)
    v_fma_mix_f32 v24, v88, v32, v36 op_sel_hi:[1,0,0]
    v_fma_mix_f32 v25, v89, v33, v37 op_sel_hi:[1,0,0]
    buffer_load_dwordx4 v[76:79], v5, s[8:11], s29 offen
    v_fma_mix_f32 v26, v90, v34, v38 op_sel_hi:[1,0,0]
    v_fma_mix_f32 v27, v91, v35, v39 op_sel_hi:[1,0,0]
    v_fma_mix_f32 v28, v92, v32, v36 op_sel_hi:[1,0,0]
    v_fma_mix_f32 v29, v93, v33, v37 op_sel_hi:[1,0,0]
    v_fma_mix_f32 v30, v94, v34, v38 op_sel_hi:[1,0,0]
    buffer_load_dwordx4 v[80:83], v6, s[8:11], s29 offen
    v_fma_mix_f32 v31, v95, v35, v39 op_sel_hi:[1,0,0]
    v_cvt_pk_bf16_f32 v51, v24, v28
    v_cvt_pk_bf16_f32 v55, v25, v29
    v_cvt_pk_bf16_f32 v59, v26, v30
    v_cvt_pk_bf16_f32 v63, v27, v31
    buffer_load_dwordx4 v[84:87], v7, s[8:11], s29 offen
    ds_write_b128 v19, v[48:51]
    buffer_load_dwordx4 v[88:91], v8, s[8:11], s29 offen
    ds_write_b128 v19, v[52:55] offset:1024
    s_lshl_b32 s30, s37, 7
    s_add_u32 s31, s31, 32768
    s_cmp_eq_u32 s31, s33
    s_cselect_b32 s31, s32, s31
    buffer_load_dwordx4 v[92:95], v9, s[8:11], s29 offen
    s_mov_b32 m0, s31
    ds_write_b128 v19, v[56:59] offset:2048
    buffer_load_dwordx4 v10, s[4:7], s30 offen lds
    ds_write_b128 v19, v[60:63] offset:3072
    buffer_load_dwordx4 v11, s[4:7], s30 offen offset:1024 lds
    v_lshl_add_u32 v20, s37, 10, v21
    buffer_load_dwordx4 v12, s[4:7], s30 offen offset:2048 lds
    s_waitcnt vmcnt(11) lgkmcnt(0)
    s_barrier
    s_branch L_ploop
L_pexit:
    buffer_load_dwordx4 v13, s[4:7], s30 offen offset:3072 lds
    ds_read_b128 v[32:35], v20
    ds_read_b128 v[36:39], v20 offset:16384
    s_and_b32 s37, s42, 15
    s_mul_i32 s29, s37, 917504
    s_mov_b32 s36, s30
    s_mov_b32 m0, s32
    s_lshl_b32 s30, s37, 7
    buffer_load_dwordx4 v10, s[4:7], s30 offen lds
    s_waitcnt vmcnt(11) lgkmcnt(0)
    v_fma_mix_f32 v24, v64, v32, v36 op_sel_hi:[1,0,0]
    v_fma_mix_f32 v25, v65, v33, v37 op_sel_hi:[1,0,0]
    v_fma_mix_f32 v26, v66, v34, v38 op_sel_hi:[1,0,0]
    v_fma_mix_f32 v27, v67, v35, v39 op_sel_hi:[1,0,0]
    v_fma_mix_f32 v28, v68, v32, v36 op_sel_hi:[1,0,0]
    v_fma_mix_f32 v29, v69, v33, v37 op_sel_hi:[1,0,0]
    buffer_load_dwordx4 v11, s[4:7], s30 offen offset:1024 lds
    v_fma_mix_f32 v30, v70, v34, v38 op_sel_hi:[1,0,0]
    v_fma_mix_f32 v31, v71, v35, v39 op_sel_hi:[1,0,0]
    v_cvt_pk_bf16_f32 v48, v24, v28
    v_cvt_pk_bf16_f32 v52, v25, v29
    v_cvt_pk_bf16_f32 v56, v26, v30
    buffer_load_dwordx4 v12, s[4:7], s30 offen offset:2048 lds
    v_cvt_pk_bf16_f32 v60, v27, v31
    s_waitcnt vmcnt(11)
    v_fma_mix_f32 v24, v72, v32, v36 op_sel_hi:[1,0,0]
    v_fma_mix_f32 v25, v73, v33, v37 op_sel_hi:[1,0,0]
    v_fma_mix_f32 v26, v74, v34, v38 op_sel_hi:[1,0,0]
    v_fma_mix_f32 v27, v75, v35, v39 op_sel_hi:[1,0,0]
    buffer_load_dwordx4 v13, s[4:7], s30 offen offset:3072 lds
    s_add_u32 m0, s32, 4096
    s_nop 0
    v_fma_mix_f32 v28, v76, v32, v36 op_sel_hi:[1,0,0]
    v_fma_mix_f32 v29, v77, v33, v37 op_sel_hi:[1,0,0]
    v_fma_mix_f32 v30, v78, v34, v38 op_sel_hi:[1,0,0]
    v_fma_mix_f32 v31, v79, v35, v39 op_sel_hi:[1,0,0]
    v_cvt_pk_bf16_f32 v49, v24, v28
    v_cvt_pk_bf16_f32 v53, v25, v29
    buffer_load_dwordx4 v[96:99], v2, s[8:11], s29 offen
    v_cvt_pk_bf16_f32 v57, v26, v30
    v_cvt_pk_bf16_f32 v61, v27, v31
    s_waitcnt vmcnt(11)
    v_fma_mix_f32 v24, v80, v32, v36 op_sel_hi:[1,0,0]
    v_fma_mix_f32 v25, v81, v33, v37 op_sel_hi:[1,0,0]
    v_fma_mix_f32 v26, v82, v34, v38 op_sel_hi:[1,0,0]
    buffer_load_dwordx4 v[100:103], v3, s[8:11], s29 offen
    v_fma_mix_f32 v27, v83, v35, v39 op_sel_hi:[1,0,0]
    v_fma_mix_f32 v28, v84, v32, v36 op_sel_hi:[1,0,0]
    v_fma_mix_f32 v29, v85, v33, v37 op_sel_hi:[1,0,0]
    v_fma_mix_f32 v30, v86, v34, v38 op_sel_hi:[1,0,0]
    v_fma_mix_f32 v31, v87, v35, v39 op_sel_hi:[1,0,0]
    buffer_load_dwordx4 v[104:107], v4, s[8:11], s29 offen
    v_cvt_pk_bf16_f32 v50, v24, v28
    v_cvt_pk_bf16_f32 v54, v25, v29
    v_cvt_pk_bf16_f32 v58, v26, v30
    v_cvt_pk_bf16_f32 v62, v27, v31
    s_waitcnt vmcnt(11)
    v_fma_mix_f32 v24, v88, v32, v36 op_sel_hi:[1,0,0]
    v_fma_mix_f32 v25, v89, v33, v37 op_sel_hi:[1,0,0]
    buffer_load_dwordx4 v[108:111], v5, s[8:11], s29 offen
    v_fma_mix_f32 v26, v90, v34, v38 op_sel_hi:[1,0,0]
    v_fma_mix_f32 v27, v91, v35, v39 op_sel_hi:[1,0,0]
    v_fma_mix_f32 v28, v92, v32, v36 op_sel_hi:[1,0,0]
    v_fma_mix_f32 v29, v93, v33, v37 op_sel_hi:[1,0,0]
    v_fma_mix_f32 v30, v94, v34, v38 op_sel_hi:[1,0,0]
    buffer_load_dwordx4 v[112:115], v6, s[8:11], s29 offen
    v_fma_mix_f32 v31, v95, v35, v39 op_sel_hi:[1,0,0]
    v_cvt_pk_bf16_f32 v51, v24, v28
    v_cvt_pk_bf16_f32 v55, v25, v29
    v_cvt_pk_bf16_f32 v59, v26, v30
    v_cvt_pk_bf16_f32 v63, v27, v31
    buffer_load_dwordx4 v[116:119], v7, s[8:11], s29 offen
    v_lshl_add_u32 v20, s37, 10, v21
    ds_write_b128 v19, v[48:51]
    buffer_load_dwordx4 v[120:123], v8, s[8:11], s29 offen
    ds_write_b128 v19, v[52:55] offset:1024
    buffer_load_dwordx4 v[124:127], v9, s[8:11], s29 offen
    ds_write_b128 v19, v[56:59] offset:2048
    buffer_load_dwordx4 v14, s[4:7], s30 offen lds
    ds_write_b128 v19, v[60:63] offset:3072
    ds_read_b128 v[128:131], v20
    ds_read_b128 v[132:135], v20 offset:16384
    buffer_load_dwordx4 v15, s[4:7], s30 offen offset:1024 lds
    buffer_load_dwordx4 v16, s[4:7], s30 offen offset:2048 lds
    s_waitcnt vmcnt(15) lgkmcnt(0)
    s_barrier
    buffer_load_dwordx4 v17, s[4:7], s30 offen offset:3072 lds
    s_waitcnt vmcnt(10) lgkmcnt(0)
    v_fma_mix_f32 v24, v96, v128, v132 op_sel_hi:[1,0,0]
    v_fma_mix_f32 v25, v97, v129, v133 op_sel_hi:[1,0,0]
    v_fma_mix_f32 v26, v98, v130, v134 op_sel_hi:[1,0,0]
    v_fma_mix_f32 v27, v99, v131, v135 op_sel_hi:[1,0,0]
    v_fma_mix_f32 v28, v100, v128, v132 op_sel_hi:[1,0,0]
    v_fma_mix_f32 v29, v101, v129, v133 op_sel_hi:[1,0,0]
    v_fma_mix_f32 v30, v102, v130, v134 op_sel_hi:[1,0,0]
    v_fma_mix_f32 v31, v103, v131, v135 op_sel_hi:[1,0,0]
    v_cvt_pk_bf16_f32 v136, v24, v28
    v_cvt_pk_bf16_f32 v140, v25, v29
    v_cvt_pk_bf16_f32 v144, v26, v30
    v_cvt_pk_bf16_f32 v148, v27, v31
    s_waitcnt vmcnt(8)
    v_fma_mix_f32 v24, v104, v128, v132 op_sel_hi:[1,0,0]
    v_fma_mix_f32 v25, v105, v129, v133 op_sel_hi:[1,0,0]
    v_fma_mix_f32 v26, v106, v130, v134 op_sel_hi:[1,0,0]
    v_fma_mix_f32 v27, v107, v131, v135 op_sel_hi:[1,0,0]
    v_fma_mix_f32 v28, v108, v128, v132 op_sel_hi:[1,0,0]
    v_fma_mix_f32 v29, v109, v129, v133 op_sel_hi:[1,0,0]
    v_fma_mix_f32 v30, v110, v130, v134 op_sel_hi:[1,0,0]
    v_fma_mix_f32 v31, v111, v131, v135 op_sel_hi:[1,0,0]
    v_cvt_pk_bf16_f32 v137, v24, v28
    v_cvt_pk_bf16_f32 v141, v25, v29
    v_cvt_pk_bf16_f32 v145, v26, v30
    v_cvt_pk_bf16_f32 v149, v27, v31
    s_waitcnt vmcnt(6)
    v_fma_mix_f32 v24, v112, v128, v132 op_sel_hi:[1,0,0]
    v_fma_mix_f32 v25, v113, v129, v133 op_sel_hi:[1,0,0]
    v_fma_mix_f32 v26, v114, v130, v134 op_sel_hi:[1,0,0]
    v_fma_mix_f32 v27, v115, v131, v135 op_sel_hi:[1,0,0]
    v_fma_mix_f32 v28, v116, v128, v132 op_sel_hi:[1,0,0]
    v_fma_mix_f32 v29, v117, v129, v133 op_sel_hi:[1,0,0]
    v_fma_mix_f32 v30, v118, v130, v134 op_sel_hi:[1,0,0]
    v_fma_mix_f32 v31, v119, v131, v135 op_sel_hi:[1,0,0]
    v_cvt_pk_bf16_f32 v138, v24, v28
    v_cvt_pk_bf16_f32 v142, v25, v29
    v_cvt_pk_bf16_f32 v146, v26, v30
    v_cvt_pk_bf16_f32 v150, v27, v31
    s_waitcnt vmcnt(4)
    v_fma_mix_f32 v24, v120, v128, v132 op_sel_hi:[1,0,0]
    v_fma_mix_f32 v25, v121, v129, v133 op_sel_hi:[1,0,0]
    v_fma_mix_f32 v26, v122, v130, v134 op_sel_hi:[1,0,0]
    v_fma_mix_f32 v27, v123, v131, v135 op_sel_hi:[1,0,0]
    v_fma_mix_f32 v28, v124, v128, v132 op_sel_hi:[1,0,0]
    v_fma_mix_f32 v29, v125, v129, v133 op_sel_hi:[1,0,0]
    v_fma_mix_f32 v30, v126, v130, v134 op_sel_hi:[1,0,0]
    v_fma_mix_f32 v31, v127, v131, v135 op_sel_hi:[1,0,0]
    v_cvt_pk_bf16_f32 v139, v24, v28
    v_cvt_pk_bf16_f32 v143, v25, v29
    v_cvt_pk_bf16_f32 v147, v26, v30
    v_cvt_pk_bf16_f32 v151, v27, v31
    ds_write_b128 v19, v[136:139] offset:16384
    ds_write_b128 v19, v[140:143] offset:17408
    ds_write_b128 v19, v[144:147] offset:18432
    ds_write_b128 v19, v[148:151] offset:19456
    s_add_u32 m0, s32, 69632
    s_mov_b32 s30, s36
    s_waitcnt vmcnt(0) lgkmcnt(0)
    s_barrier
    buffer_load_dwordx4 v14, s[4:7], s30 offen lds
    buffer_load_dwordx4 v15, s[4:7], s30 offen offset:1024 lds
    buffer_load_dwordx4 v16, s[4:7], s30 offen offset:2048 lds
    buffer_load_dwordx4 v17, s[4:7], s30 offen offset:3072 lds
    s_waitcnt vmcnt(0)
    s_barrier
    s_endpgm
L_consumer2:
    s_waitcnt lgkmcnt(0)
    s_barrier
    ds_read_b128 v[128:131], v224
    ds_read_b128 v[192:195], v228
    ds_read_b128 v[132:135], v225
    ds_read_b128 v[196:199], v228 offset:8192
    ds_read_b128 v[136:139], v224 offset:2048
    ds_read_b128 v[140:143], v225 offset:2048
    ds_read_b128 v[200:203], v228 offset:1024
    ds_read_b128 v[204:207], v228 offset:9216
    .p2align 3
L_cloop:
    s_waitcnt lgkmcnt(4)
    v_mfma_f32_16x16x32_bf16 v[0:3], v[128:131], v[192:195], v[0:3]
    ds_read_b128 v[144:147], v224 offset:4096
    v_mfma_f32_16x16x32_bf16 v[0:3], v[132:135], v[196:199], v[0:3]
    s_waitcnt lgkmcnt(1)
    v_mfma_f32_16x16x32_bf16 v[4:7], v[132:135], v[204:207], v[4:7]
    ds_read_b128 v[148:151], v225 offset:4096
    v_mfma_f32_16x16x32_bf16 v[4:7], v[128:131], v[200:203], v[4:7]
    v_mfma_f32_16x16x32_bf16 v[36:39], v[136:139], v[200:203], v[36:39]
    ds_read_b128 v[152:155], v224 offset:6144
    v_mfma_f32_16x16x32_bf16 v[36:39], v[140:143], v[204:207], v[36:39]
    v_mfma_f32_16x16x32_bf16 v[32:35], v[140:143], v[196:199], v[32:35]
    ds_read_b128 v[156:159], v225 offset:6144
    v_mfma_f32_16x16x32_bf16 v[32:35], v[136:139], v[192:195], v[32:35]
    s_waitcnt lgkmcnt(2)
    v_mfma_f32_16x16x32_bf16 v[64:67], v[144:147], v[192:195], v[64:67]
    ds_read_b128 v[208:211], v228 offset:2048
    v_mfma_f32_16x16x32_bf16 v[64:67], v[148:151], v[196:199], v[64:67]
    v_mfma_f32_16x16x32_bf16 v[68:71], v[148:151], v[204:207], v[68:71]
    ds_read_b128 v[212:215], v228 offset:10240
    v_mfma_f32_16x16x32_bf16 v[68:71], v[144:147], v[200:203], v[68:71]
    s_waitcnt lgkmcnt(2)
    v_mfma_f32_16x16x32_bf16 v[100:103], v[152:155], v[200:203], v[100:103]
    ds_read_b128 v[216:219], v228 offset:3072
    v_mfma_f32_16x16x32_bf16 v[100:103], v[156:159], v[204:207], v[100:103]
    v_add_u32 v224, s31, v226
    v_mfma_f32_16x16x32_bf16 v[96:99], v[156:159], v[196:199], v[96:99]
    ds_read_b128 v[220:223], v228 offset:11264
    v_mfma_f32_16x16x32_bf16 v[96:99], v[152:155], v[192:195], v[96:99]
    v_add_u32 v225, s31, v227
    s_waitcnt lgkmcnt(2)
    v_mfma_f32_16x16x32_bf16 v[104:107], v[152:155], v[208:211], v[104:107]
    ds_read_b128 v[192:195], v229 offset:4096
    v_mfma_f32_16x16x32_bf16 v[104:107], v[156:159], v[212:215], v[104:107]
    s_add_u32 s31, s31, 32768
    v_mfma_f32_16x16x32_bf16 v[72:75], v[148:151], v[212:215], v[72:75]
    ds_read_b128 v[196:199], v229 offset:12288
    v_mfma_f32_16x16x32_bf16 v[72:75], v[144:147], v[208:211], v[72:75]
    s_cmp_eq_u32 s31, 98304
    s_cselect_b32 s31, 0, s31
    v_mfma_f32_16x16x32_bf16 v[40:43], v[136:139], v[208:211], v[40:43]
    ds_read_b128 v[200:203], v229 offset:5120
    v_mfma_f32_16x16x32_bf16 v[40:43], v[140:143], v[212:215], v[40:43]
    v_mfma_f32_16x16x32_bf16 v[8:11], v[132:135], v[212:215], v[8:11]
    ds_read_b128 v[204:207], v229 offset:13312
    v_mfma_f32_16x16x32_bf16 v[8:11], v[128:131], v[208:211], v[8:11]
    s_waitcnt lgkmcnt(4)
    v_mfma_f32_16x16x32_bf16 v[12:15], v[128:131], v[216:219], v[12:15]
    v_mfma_f32_16x16x32_bf16 v[12:15], v[132:135], v[220:223], v[12:15]
    ds_read_b128 v[208:211], v229 offset:6144
    v_mfma_f32_16x16x32_bf16 v[44:47], v[140:143], v[220:223], v[44:47]
    v_mfma_f32_16x16x32_bf16 v[44:47], v[136:139], v[216:219], v[44:47]
    v_mfma_f32_16x16x32_bf16 v[76:79], v[144:147], v[216:219], v[76:79]
    ds_read_b128 v[212:215], v229 offset:14336
    v_mfma_f32_16x16x32_bf16 v[76:79], v[148:151], v[220:223], v[76:79]
    v_mfma_f32_16x16x32_bf16 v[108:111], v[156:159], v[220:223], v[108:111]
    v_mfma_f32_16x16x32_bf16 v[108:111], v[152:155], v[216:219], v[108:111]
    s_waitcnt lgkmcnt(4)
    v_mfma_f32_16x16x32_bf16 v[112:115], v[152:155], v[192:195], v[112:115]
    ds_read_b128 v[216:219], v229 offset:7168
    v_mfma_f32_16x16x32_bf16 v[112:115], v[156:159], v[196:199], v[112:115]
    ds_read_b128 v[220:223], v229 offset:15360
    v_mfma_f32_16x16x32_bf16 v[80:83], v[148:151], v[196:199], v[80:83]
    v_mfma_f32_16x16x32_bf16 v[80:83], v[144:147], v[192:195], v[80:83]
    v_mfma_f32_16x16x32_bf16 v[48:51], v[136:139], v[192:195], v[48:51]
    v_mfma_f32_16x16x32_bf16 v[48:51], v[140:143], v[196:199], v[48:51]
    v_mfma_f32_16x16x32_bf16 v[16:19], v[132:135], v[196:199], v[16:19]
    v_mfma_f32_16x16x32_bf16 v[16:19], v[128:131], v[192:195], v[16:19]
    s_waitcnt lgkmcnt(4)
    v_mfma_f32_16x16x32_bf16 v[20:23], v[128:131], v[200:203], v[20:23]
    v_mfma_f32_16x16x32_bf16 v[20:23], v[132:135], v[204:207], v[20:23]
    v_mfma_f32_16x16x32_bf16 v[52:55], v[140:143], v[204:207], v[52:55]
    v_mfma_f32_16x16x32_bf16 v[52:55], v[136:139], v[200:203], v[52:55]
    v_mfma_f32_16x16x32_bf16 v[84:87], v[144:147], v[200:203], v[84:87]
    v_mfma_f32_16x16x32_bf16 v[84:87], v[148:151], v[204:207], v[84:87]
    v_mfma_f32_16x16x32_bf16 v[116:119], v[156:159], v[204:207], v[116:119]
    v_mfma_f32_16x16x32_bf16 v[116:119], v[152:155], v[200:203], v[116:119]
    s_waitcnt lgkmcnt(0)
    s_barrier
    v_mfma_f32_16x16x32_bf16 v[120:123], v[152:155], v[208:211], v[120:123]
    ds_read_b128 v[160:163], v224
    v_mfma_f32_16x16x32_bf16 v[120:123], v[156:159], v[212:215], v[120:123]
    ds_read_b128 v[192:195], v228 offset:16384
    v_mfma_f32_16x16x32_bf16 v[88:91], v[148:151], v[212:215], v[88:91]
    v_mfma_f32_16x16x32_bf16 v[88:91], v[144:147], v[208:211], v[88:91]
    ds_read_b128 v[164:167], v225
    v_mfma_f32_16x16x32_bf16 v[56:59], v[136:139], v[208:211], v[56:59]
    v_mfma_f32_16x16x32_bf16 v[56:59], v[140:143], v[212:215], v[56:59]
    ds_read_b128 v[196:199], v228 offset:24576
    v_mfma_f32_16x16x32_bf16 v[24:27], v[132:135], v[212:215], v[24:27]
    v_mfma_f32_16x16x32_bf16 v[24:27], v[128:131], v[208:211], v[24:27]
    ds_read_b128 v[168:171], v224 offset:2048
    v_mfma_f32_16x16x32_bf16 v[28:31], v[128:131], v[216:219], v[28:31]
    ds_read_b128 v[172:175], v225 offset:2048
    v_mfma_f32_16x16x32_bf16 v[28:31], v[132:135], v[220:223], v[28:31]
    v_mfma_f32_16x16x32_bf16 v[60:63], v[140:143], v[220:223], v[60:63]
    ds_read_b128 v[200:203], v228 offset:17408
    v_mfma_f32_16x16x32_bf16 v[60:63], v[136:139], v[216:219], v[60:63]
    v_mfma_f32_16x16x32_bf16 v[92:95], v[144:147], v[216:219], v[92:95]
    ds_read_b128 v[204:207], v228 offset:25600
    v_mfma_f32_16x16x32_bf16 v[92:95], v[148:151], v[220:223], v[92:95]
    v_mfma_f32_16x16x32_bf16 v[124:127], v[156:159], v[220:223], v[124:127]
    v_mfma_f32_16x16x32_bf16 v[124:127], v[152:155], v[216:219], v[124:127]
    s_waitcnt lgkmcnt(4)
    v_mfma_f32_16x16x32_bf16 v[0:3], v[160:163], v[192:195], v[0:3]
    ds_read_b128 v[176:179], v224 offset:4096
    v_mfma_f32_16x16x32_bf16 v[0:3], v[164:167], v[196:199], v[0:3]
    s_waitcnt lgkmcnt(1)
    v_mfma_f32_16x16x32_bf16 v[4:7], v[164:167], v[204:207], v[4:7]
    ds_read_b128 v[180:183], v225 offset:4096
    v_mfma_f32_16x16x32_bf16 v[4:7], v[160:163], v[200:203], v[4:7]
    v_mfma_f32_16x16x32_bf16 v[36:39], v[168:171], v[200:203], v[36:39]
    ds_read_b128 v[184:187], v224 offset:6144
    v_mfma_f32_16x16x32_bf16 v[36:39], v[172:175], v[204:207], v[36:39]
    v_mfma_f32_16x16x32_bf16 v[32:35], v[172:175], v[196:199], v[32:35]
    ds_read_b128 v[188:191], v225 offset:6144
    v_mfma_f32_16x16x32_bf16 v[32:35], v[168:171], v[192:195], v[32:35]
    s_waitcnt lgkmcnt(2)
    v_mfma_f32_16x16x32_bf16 v[64:67], v[176:179], v[192:195], v[64:67]
    ds_read_b128 v[208:211], v228 offset:18432
    v_mfma_f32_16x16x32_bf16 v[64:67], v[180:183], v[196:199], v[64:67]
    v_mfma_f32_16x16x32_bf16 v[68:71], v[180:183], v[204:207], v[68:71]
    ds_read_b128 v[212:215], v228 offset:26624
    v_mfma_f32_16x16x32_bf16 v[68:71], v[176:179], v[200:203], v[68:71]
    s_waitcnt lgkmcnt(2)
    v_mfma_f32_16x16x32_bf16 v[100:103], v[184:187], v[200:203], v[100:103]
    ds_read_b128 v[216:219], v228 offset:19456
    v_mfma_f32_16x16x32_bf16 v[100:103], v[188:191], v[204:207], v[100:103]
    v_add_u32 v224, s31, v226
    v_mfma_f32_16x16x32_bf16 v[96:99], v[188:191], v[196:199], v[96:99]
    ds_read_b128 v[220:223], v228 offset:27648
    v_mfma_f32_16x16x32_bf16 v[96:99], v[184:187], v[192:195], v[96:99]
    v_add_u32 v225, s31, v227
    s_waitcnt lgkmcnt(2)
    v_mfma_f32_16x16x32_bf16 v[104:107], v[184:187], v[208:211], v[104:107]
    ds_read_b128 v[192:195], v229 offset:20480
    v_mfma_f32_16x16x32_bf16 v[104:107], v[188:191], v[212:215], v[104:107]
    s_add_u32 s31, s31, 32768
    v_mfma_f32_16x16x32_bf16 v[72:75], v[180:183], v[212:215], v[72:75]
    ds_read_b128 v[196:199], v229 offset:28672
    v_mfma_f32_16x16x32_bf16 v[72:75], v[176:179], v[208:211], v[72:75]
    s_cmp_eq_u32 s31, 98304
    s_cselect_b32 s31, 0, s31
    v_mfma_f32_16x16x32_bf16 v[40:43], v[168:171], v[208:211], v[40:43]
    ds_read_b128 v[200:203], v229 offset:21504
    v_mfma_f32_16x16x32_bf16 v[40:43], v[172:175], v[212:215], v[40:43]
    v_mfma_f32_16x16x32_bf16 v[8:11], v[164:167], v[212:215], v[8:11]
    ds_read_b128 v[204:207], v229 offset:29696
    v_mfma_f32_16x16x32_bf16 v[8:11], v[160:163], v[208:211], v[8:11]
    s_waitcnt lgkmcnt(4)
    v_mfma_f32_16x16x32_bf16 v[12:15], v[160:163], v[216:219], v[12:15]
    v_mfma_f32_16x16x32_bf16 v[12:15], v[164:167], v[220:223], v[12:15]
    ds_read_b128 v[208:211], v229 offset:22528
    v_mfma_f32_16x16x32_bf16 v[44:47], v[172:175], v[220:223], v[44:47]
    v_mfma_f32_16x16x32_bf16 v[44:47], v[168:171], v[216:219], v[44:47]
    v_mfma_f32_16x16x32_bf16 v[76:79], v[176:179], v[216:219], v[76:79]
    ds_read_b128 v[212:215], v229 offset:30720
    v_mfma_f32_16x16x32_bf16 v[76:79], v[180:183], v[220:223], v[76:79]
    v_mfma_f32_16x16x32_bf16 v[108:111], v[188:191], v[220:223], v[108:111]
    v_mfma_f32_16x16x32_bf16 v[108:111], v[184:187], v[216:219], v[108:111]
    s_waitcnt lgkmcnt(4)
    v_mfma_f32_16x16x32_bf16 v[112:115], v[184:187], v[192:195], v[112:115]
    ds_read_b128 v[216:219], v229 offset:23552
    v_mfma_f32_16x16x32_bf16 v[112:115], v[188:191], v[196:199], v[112:115]
    ds_read_b128 v[220:223], v229 offset:31744
    v_mfma_f32_16x16x32_bf16 v[80:83], v[180:183], v[196:199], v[80:83]
    v_mfma_f32_16x16x32_bf16 v[80:83], v[176:179], v[192:195], v[80:83]
    v_mfma_f32_16x16x32_bf16 v[48:51], v[168:171], v[192:195], v[48:51]
    v_mfma_f32_16x16x32_bf16 v[48:51], v[172:175], v[196:199], v[48:51]
    v_mfma_f32_16x16x32_bf16 v[16:19], v[164:167], v[196:199], v[16:19]
    v_mfma_f32_16x16x32_bf16 v[16:19], v[160:163], v[192:195], v[16:19]
    s_waitcnt lgkmcnt(4)
    v_mfma_f32_16x16x32_bf16 v[20:23], v[160:163], v[200:203], v[20:23]
    v_mfma_f32_16x16x32_bf16 v[20:23], v[164:167], v[204:207], v[20:23]
    v_mfma_f32_16x16x32_bf16 v[52:55], v[172:175], v[204:207], v[52:55]
    v_mfma_f32_16x16x32_bf16 v[52:55], v[168:171], v[200:203], v[52:55]
    v_mfma_f32_16x16x32_bf16 v[84:87], v[176:179], v[200:203], v[84:87]
    v_mfma_f32_16x16x32_bf16 v[84:87], v[180:183], v[204:207], v[84:87]
    v_mfma_f32_16x16x32_bf16 v[116:119], v[188:191], v[204:207], v[116:119]
    v_mfma_f32_16x16x32_bf16 v[116:119], v[184:187], v[200:203], v[116:119]
    s_waitcnt lgkmcnt(0)
    s_barrier
    v_mfma_f32_16x16x32_bf16 v[120:123], v[184:187], v[208:211], v[120:123]
    ds_read_b128 v[128:131], v224
    v_mfma_f32_16x16x32_bf16 v[120:123], v[188:191], v[212:215], v[120:123]
    ds_read_b128 v[192:195], v228
    v_mfma_f32_16x16x32_bf16 v[88:91], v[180:183], v[212:215], v[88:91]
    v_mfma_f32_16x16x32_bf16 v[88:91], v[176:179], v[208:211], v[88:91]
    ds_read_b128 v[132:135], v225
    v_mfma_f32_16x16x32_bf16 v[56:59], v[168:171], v[208:211], v[56:59]
    v_mfma_f32_16x16x32_bf16 v[56:59], v[172:175], v[212:215], v[56:59]
    ds_read_b128 v[196:199], v228 offset:8192
    v_mfma_f32_16x16x32_bf16 v[24:27], v[164:167], v[212:215], v[24:27]
    v_mfma_f32_16x16x32_bf16 v[24:27], v[160:163], v[208:211], v[24:27]
    ds_read_b128 v[136:139], v224 offset:2048
    v_mfma_f32_16x16x32_bf16 v[28:31], v[160:163], v[216:219], v[28:31]
    ds_read_b128 v[140:143], v225 offset:2048
    v_mfma_f32_16x16x32_bf16 v[28:31], v[164:167], v[220:223], v[28:31]
    s_sub_u32 s34, s34, 1
    v_mfma_f32_16x16x32_bf16 v[60:63], v[172:175], v[220:223], v[60:63]
    ds_read_b128 v[200:203], v228 offset:1024
    v_mfma_f32_16x16x32_bf16 v[60:63], v[168:171], v[216:219], v[60:63]
    v_mfma_f32_16x16x32_bf16 v[92:95], v[176:179], v[216:219], v[92:95]
    ds_read_b128 v[204:207], v228 offset:9216
    v_mfma_f32_16x16x32_bf16 v[92:95], v[180:183], v[220:223], v[92:95]
    v_mfma_f32_16x16x32_bf16 v[124:127], v[188:191], v[220:223], v[124:127]
    v_mfma_f32_16x16x32_bf16 v[124:127], v[184:187], v[216:219], v[124:127]
    s_cbranch_scc0 L_cloop
    s_waitcnt lgkmcnt(4)
    v_mfma_f32_16x16x32_bf16 v[0:3], v[128:131], v[192:195], v[0:3]
    ds_read_b128 v[208:211], v228 offset:2048
    v_mfma_f32_16x16x32_bf16 v[0:3], v[132:135], v[196:199], v[0:3]
    ds_read_b128 v[212:215], v228 offset:10240
    s_waitcnt lgkmcnt(4)
    v_mfma_f32_16x16x32_bf16 v[32:35], v[140:143], v[196:199], v[32:35]
    ds_read_b128 v[216:219], v228 offset:3072
    v_mfma_f32_16x16x32_bf16 v[32:35], v[136:139], v[192:195], v[32:35]
    ds_read_b128 v[220:223], v228 offset:11264
    s_waitcnt lgkmcnt(4)
    v_mfma_f32_16x16x32_bf16 v[36:39], v[136:139], v[200:203], v[36:39]
    ds_read_b128 v[144:147], v229 offset:4096
    v_mfma_f32_16x16x32_bf16 v[36:39], v[140:143], v[204:207], v[36:39]
    ds_read_b128 v[148:151], v229 offset:12288
    v_mfma_f32_16x16x32_bf16 v[4:7], v[132:135], v[204:207], v[4:7]
    ds_read_b128 v[152:155], v229 offset:5120
    v_mfma_f32_16x16x32_bf16 v[4:7], v[128:131], v[200:203], v[4:7]
    ds_read_b128 v[156:159], v229 offset:13312
    s_waitcnt lgkmcnt(6)
    v_mfma_f32_16x16x32_bf16 v[8:11], v[128:131], v[208:211], v[8:11]
    ds_read_b128 v[192:195], v229 offset:6144
    v_mfma_f32_16x16x32_bf16 v[8:11], v[132:135], v[212:215], v[8:11]
    ds_read_b128 v[196:199], v229 offset:14336
    v_mfma_f32_16x16x32_bf16 v[40:43], v[140:143], v[212:215], v[40:43]
    ds_read_b128 v[200:203], v229 offset:7168
    v_mfma_f32_16x16x32_bf16 v[40:43], v[136:139], v[208:211], v[40:43]
    ds_read_b128 v[204:207], v229 offset:15360
    s_waitcnt lgkmcnt(8)
    v_mfma_f32_16x16x32_bf16 v[44:47], v[136:139], v[216:219], v[44:47]
    v_mfma_f32_16x16x32_bf16 v[44:47], v[140:143], v[220:223], v[44:47]
    v_mfma_f32_16x16x32_bf16 v[12:15], v[132:135], v[220:223], v[12:15]
    v_mfma_f32_16x16x32_bf16 v[12:15], v[128:131], v[216:219], v[12:15]
    s_waitcnt lgkmcnt(6)
    v_mfma_f32_16x16x32_bf16 v[16:19], v[128:131], v[144:147], v[16:19]
    v_mfma_f32_16x16x32_bf16 v[16:19], v[132:135], v[148:151], v[16:19]
    v_mfma_f32_16x16x32_bf16 v[48:51], v[140:143], v[148:151], v[48:51]
    v_mfma_f32_16x16x32_bf16 v[48:51], v[136:139], v[144:147], v[48:51]
    s_waitcnt lgkmcnt(4)
    v_mfma_f32_16x16x32_bf16 v[52:55], v[136:139], v[152:155], v[52:55]
    v_mfma_f32_16x16x32_bf16 v[52:55], v[140:143], v[156:159], v[52:55]
    s_barrier
    v_mfma_f32_16x16x32_bf16 v[20:23], v[132:135], v[156:159], v[20:23]
    ds_read_b128 v[160:163], v226
    v_mfma_f32_16x16x32_bf16 v[20:23], v[128:131], v[152:155], v[20:23]
    ds_read_b128 v[176:179], v228 offset:16384
    s_waitcnt lgkmcnt(4)
    v_mfma_f32_16x16x32_bf16 v[24:27], v[128:131], v[192:195], v[24:27]
    ds_read_b128 v[164:167], v227
    v_mfma_f32_16x16x32_bf16 v[24:27], v[132:135], v[196:199], v[24:27]
    ds_read_b128 v[180:183], v228 offset:24576
    v_mfma_f32_16x16x32_bf16 v[56:59], v[140:143], v[196:199], v[56:59]
    ds_read_b128 v[184:187], v228 offset:17408
    v_mfma_f32_16x16x32_bf16 v[56:59], v[136:139], v[192:195], v[56:59]
    ds_read_b128 v[188:191], v228 offset:25600
    s_waitcnt lgkmcnt(6)
    v_mfma_f32_16x16x32_bf16 v[60:63], v[136:139], v[200:203], v[60:63]
    ds_read_b128 v[208:211], v228 offset:18432
    v_mfma_f32_16x16x32_bf16 v[60:63], v[140:143], v[204:207], v[60:63]
    ds_read_b128 v[212:215], v228 offset:26624
    v_mfma_f32_16x16x32_bf16 v[28:31], v[132:135], v[204:207], v[28:31]
    ds_read_b128 v[216:219], v228 offset:19456
    v_mfma_f32_16x16x32_bf16 v[28:31], v[128:131], v[200:203], v[28:31]
    ds_read_b128 v[220:223], v228 offset:27648
    s_waitcnt lgkmcnt(6)
    v_mfma_f32_16x16x32_bf16 v[0:3], v[160:163], v[176:179], v[0:3]
    ds_read_b128 v[144:147], v229 offset:20480
    v_mfma_f32_16x16x32_bf16 v[0:3], v[164:167], v[180:183], v[0:3]
    ds_read_b128 v[148:151], v229 offset:28672
    s_waitcnt lgkmcnt(6)
    v_mfma_f32_16x16x32_bf16 v[4:7], v[164:167], v[188:191], v[4:7]
    ds_read_b128 v[152:155], v229 offset:21504
    v_mfma_f32_16x16x32_bf16 v[4:7], v[160:163], v[184:187], v[4:7]
    ds_read_b128 v[156:159], v229 offset:29696
    s_waitcnt lgkmcnt(6)
    v_mfma_f32_16x16x32_bf16 v[8:11], v[160:163], v[208:211], v[8:11]
    ds_read_b128 v[192:195], v229 offset:22528
    v_mfma_f32_16x16x32_bf16 v[8:11], v[164:167], v[212:215], v[8:11]
    ds_read_b128 v[196:199], v229 offset:30720
    s_waitcnt lgkmcnt(6)
    v_mfma_f32_16x16x32_bf16 v[12:15], v[164:167], v[220:223], v[12:15]
    ds_read_b128 v[200:203], v229 offset:23552
    v_mfma_f32_16x16x32_bf16 v[12:15], v[160:163], v[216:219], v[12:15]
    ds_read_b128 v[204:207], v229 offset:31744
    s_waitcnt lgkmcnt(6)
    v_mfma_f32_16x16x32_bf16 v[16:19], v[160:163], v[144:147], v[16:19]
    ds_read_b128 v[168:171], v226 offset:2048
    v_mfma_f32_16x16x32_bf16 v[16:19], v[164:167], v[148:151], v[16:19]
    ds_read_b128 v[172:175], v227 offset:2048
    s_waitcnt lgkmcnt(6)
    v_mfma_f32_16x16x32_bf16 v[20:23], v[164:167], v[156:159], v[20:23]
    v_mfma_f32_16x16x32_bf16 v[20:23], v[160:163], v[152:155], v[20:23]
    s_waitcnt lgkmcnt(4)
    v_mfma_f32_16x16x32_bf16 v[24:27], v[160:163], v[192:195], v[24:27]
    ds_read_b128 v[128:131], v226 offset:4096
    v_mfma_f32_16x16x32_bf16 v[24:27], v[164:167], v[196:199], v[24:27]
    ds_read_b128 v[132:135], v227 offset:4096
    s_waitcnt lgkmcnt(4)
    v_mfma_f32_16x16x32_bf16 v[28:31], v[164:167], v[204:207], v[28:31]
    ds_read_b128 v[136:139], v226 offset:6144
    v_mfma_f32_16x16x32_bf16 v[28:31], v[160:163], v[200:203], v[28:31]
    ds_read_b128 v[140:143], v227 offset:6144
    v_cvt_pk_bf16_f32 v232, v0, v4
    s_waitcnt lgkmcnt(4)
    v_mfma_f32_16x16x32_bf16 v[60:63], v[168:171], v[200:203], v[60:63]
    v_cvt_pk_bf16_f32 v233, v8, v12
    v_cvt_pk_bf16_f32 v234, v16, v20
    v_mfma_f32_16x16x32_bf16 v[60:63], v[172:175], v[204:207], v[60:63]
    v_mfma_f32_16x16x32_bf16 v[56:59], v[172:175], v[196:199], v[56:59]
    v_mfma_f32_16x16x32_bf16 v[56:59], v[168:171], v[192:195], v[56:59]
    v_cvt_pk_bf16_f32 v235, v24, v28
    s_mov_b32 s35, 0
    v_mfma_f32_16x16x32_bf16 v[52:55], v[168:171], v[152:155], v[52:55]
    buffer_store_dwordx4 v[232:235], v230, s[20:23], s35 offen sc1
    v_cvt_pk_bf16_f32 v236, v1, v5
    v_mfma_f32_16x16x32_bf16 v[52:55], v[172:175], v[156:159], v[52:55]
    v_cvt_pk_bf16_f32 v237, v9, v13
    v_cvt_pk_bf16_f32 v238, v17, v21
    v_mfma_f32_16x16x32_bf16 v[48:51], v[172:175], v[148:151], v[48:51]
    v_cvt_pk_bf16_f32 v239, v25, v29
    s_mov_b32 s35, 7168
    v_mfma_f32_16x16x32_bf16 v[48:51], v[168:171], v[144:147], v[48:51]
    buffer_store_dwordx4 v[236:239], v230, s[20:23], s35 offen sc1
    v_cvt_pk_bf16_f32 v240, v2, v6
    v_mfma_f32_16x16x32_bf16 v[44:47], v[168:171], v[216:219], v[44:47]
    v_cvt_pk_bf16_f32 v241, v10, v14
    v_cvt_pk_bf16_f32 v242, v18, v22
    v_mfma_f32_16x16x32_bf16 v[44:47], v[172:175], v[220:223], v[44:47]
    v_cvt_pk_bf16_f32 v243, v26, v30
    s_mov_b32 s35, 14336
    v_mfma_f32_16x16x32_bf16 v[40:43], v[172:175], v[212:215], v[40:43]
    buffer_store_dwordx4 v[240:243], v230, s[20:23], s35 offen sc1
    v_cvt_pk_bf16_f32 v244, v3, v7
    v_mfma_f32_16x16x32_bf16 v[40:43], v[168:171], v[208:211], v[40:43]
    v_cvt_pk_bf16_f32 v245, v11, v15
    v_cvt_pk_bf16_f32 v246, v19, v23
    v_mfma_f32_16x16x32_bf16 v[36:39], v[168:171], v[184:187], v[36:39]
    v_cvt_pk_bf16_f32 v247, v27, v31
    s_mov_b32 s35, 21504
    v_mfma_f32_16x16x32_bf16 v[36:39], v[172:175], v[188:191], v[36:39]
    buffer_store_dwordx4 v[244:247], v230, s[20:23], s35 offen sc1
    v_mfma_f32_16x16x32_bf16 v[32:35], v[172:175], v[180:183], v[32:35]
    v_mfma_f32_16x16x32_bf16 v[32:35], v[168:171], v[176:179], v[32:35]
    s_waitcnt lgkmcnt(2)
    v_mfma_f32_16x16x32_bf16 v[64:67], v[128:131], v[176:179], v[64:67]
    v_mfma_f32_16x16x32_bf16 v[64:67], v[132:135], v[180:183], v[64:67]
    s_waitcnt lgkmcnt(0)
    v_mfma_f32_16x16x32_bf16 v[96:99], v[140:143], v[180:183], v[96:99]
    v_mfma_f32_16x16x32_bf16 v[96:99], v[136:139], v[176:179], v[96:99]
    v_mfma_f32_16x16x32_bf16 v[100:103], v[136:139], v[184:187], v[100:103]
    ds_read_b128 v[176:179], v228
    v_mfma_f32_16x16x32_bf16 v[100:103], v[140:143], v[188:191], v[100:103]
    ds_read_b128 v[180:183], v228 offset:8192
    v_cvt_pk_bf16_f32 v232, v32, v36
    v_mfma_f32_16x16x32_bf16 v[68:71], v[132:135], v[188:191], v[68:71]
    v_cvt_pk_bf16_f32 v233, v40, v44
    v_cvt_pk_bf16_f32 v234, v48, v52
    v_mfma_f32_16x16x32_bf16 v[68:71], v[128:131], v[184:187], v[68:71]
    v_cvt_pk_bf16_f32 v235, v56, v60
    s_mov_b32 s35, 114688
    v_mfma_f32_16x16x32_bf16 v[72:75], v[128:131], v[208:211], v[72:75]
    ds_read_b128 v[184:187], v228 offset:1024
    buffer_store_dwordx4 v[232:235], v230, s[20:23], s35 offen sc1
    v_mfma_f32_16x16x32_bf16 v[72:75], v[132:135], v[212:215], v[72:75]
    ds_read_b128 v[188:191], v228 offset:9216
    v_cvt_pk_bf16_f32 v236, v33, v37
    v_mfma_f32_16x16x32_bf16 v[104:107], v[140:143], v[212:215], v[104:107]
    v_cvt_pk_bf16_f32 v237, v41, v45
    v_cvt_pk_bf16_f32 v238, v49, v53
    v_mfma_f32_16x16x32_bf16 v[104:107], v[136:139], v[208:211], v[104:107]
    v_cvt_pk_bf16_f32 v239, v57, v61
    s_mov_b32 s35, 121856
    s_barrier
    v_mfma_f32_16x16x32_bf16 v[108:111], v[136:139], v[216:219], v[108:111]
    ds_read_b128 v[208:211], v228 offset:2048
    buffer_store_dwordx4 v[236:239], v230, s[20:23], s35 offen sc1
    v_mfma_f32_16x16x32_bf16 v[108:111], v[140:143], v[220:223], v[108:111]
    ds_read_b128 v[212:215], v228 offset:10240
    v_cvt_pk_bf16_f32 v240, v34, v38
    v_mfma_f32_16x16x32_bf16 v[76:79], v[132:135], v[220:223], v[76:79]
    ds_read_b128 v[160:163], v224 offset:4096
    v_cvt_pk_bf16_f32 v241, v42, v46
    v_mfma_f32_16x16x32_bf16 v[76:79], v[128:131], v[216:219], v[76:79]
    ds_read_b128 v[164:167], v225 offset:4096
    v_cvt_pk_bf16_f32 v242, v50, v54
    v_mfma_f32_16x16x32_bf16 v[80:83], v[128:131], v[144:147], v[80:83]
    ds_read_b128 v[168:171], v224 offset:6144
    v_cvt_pk_bf16_f32 v243, v58, v62
    v_mfma_f32_16x16x32_bf16 v[80:83], v[132:135], v[148:151], v[80:83]
    ds_read_b128 v[172:175], v225 offset:6144
    s_mov_b32 s35, 129024
    v_mfma_f32_16x16x32_bf16 v[112:115], v[140:143], v[148:151], v[112:115]
    ds_read_b128 v[216:219], v228 offset:3072
    buffer_store_dwordx4 v[240:243], v230, s[20:23], s35 offen sc1
    v_mfma_f32_16x16x32_bf16 v[112:115], v[136:139], v[144:147], v[112:115]
    ds_read_b128 v[220:223], v228 offset:11264
    v_cvt_pk_bf16_f32 v244, v35, v39
    v_mfma_f32_16x16x32_bf16 v[116:119], v[136:139], v[152:155], v[116:119]
    ds_read_b128 v[144:147], v229 offset:4096
    v_cvt_pk_bf16_f32 v245, v43, v47
    v_mfma_f32_16x16x32_bf16 v[116:119], v[140:143], v[156:159], v[116:119]
    ds_read_b128 v[148:151], v229 offset:12288
    v_cvt_pk_bf16_f32 v246, v51, v55
    v_mfma_f32_16x16x32_bf16 v[84:87], v[132:135], v[156:159], v[84:87]
    v_cvt_pk_bf16_f32 v247, v59, v63
    s_mov_b32 s35, 136192
    v_mfma_f32_16x16x32_bf16 v[84:87], v[128:131], v[152:155], v[84:87]
    buffer_store_dwordx4 v[244:247], v230, s[20:23], s35 offen sc1
    v_mfma_f32_16x16x32_bf16 v[88:91], v[128:131], v[192:195], v[88:91]
    ds_read_b128 v[152:155], v229 offset:5120
    v_mfma_f32_16x16x32_bf16 v[88:91], v[132:135], v[196:199], v[88:91]
    ds_read_b128 v[156:159], v229 offset:13312
    v_mfma_f32_16x16x32_bf16 v[120:123], v[140:143], v[196:199], v[120:123]
    v_mfma_f32_16x16x32_bf16 v[120:123], v[136:139], v[192:195], v[120:123]
    v_mfma_f32_16x16x32_bf16 v[124:127], v[136:139], v[200:203], v[124:127]
    ds_read_b128 v[192:195], v229 offset:6144
    v_mfma_f32_16x16x32_bf16 v[124:127], v[140:143], v[204:207], v[124:127]
    ds_read_b128 v[196:199], v229 offset:14336
    v_mfma_f32_16x16x32_bf16 v[92:95], v[132:135], v[204:207], v[92:95]
    v_mfma_f32_16x16x32_bf16 v[92:95], v[128:131], v[200:203], v[92:95]
    s_waitcnt lgkmcnt(10)
    v_mfma_f32_16x16x32_bf16 v[64:67], v[160:163], v[176:179], v[64:67]
    ds_read_b128 v[200:203], v229 offset:7168
    v_mfma_f32_16x16x32_bf16 v[64:67], v[164:167], v[180:183], v[64:67]
    ds_read_b128 v[204:207], v229 offset:15360
    v_mfma_f32_16x16x32_bf16 v[68:71], v[164:167], v[188:191], v[68:71]
    v_mfma_f32_16x16x32_bf16 v[68:71], v[160:163], v[184:187], v[68:71]
    v_mfma_f32_16x16x32_bf16 v[72:75], v[160:163], v[208:211], v[72:75]
    v_mfma_f32_16x16x32_bf16 v[72:75], v[164:167], v[212:215], v[72:75]
    s_waitcnt lgkmcnt(8)
    v_mfma_f32_16x16x32_bf16 v[76:79], v[164:167], v[220:223], v[76:79]
    v_mfma_f32_16x16x32_bf16 v[76:79], v[160:163], v[216:219], v[76:79]
    s_waitcnt lgkmcnt(6)
    v_mfma_f32_16x16x32_bf16 v[80:83], v[160:163], v[144:147], v[80:83]
    v_mfma_f32_16x16x32_bf16 v[80:83], v[164:167], v[148:151], v[80:83]
    s_waitcnt lgkmcnt(4)
    v_mfma_f32_16x16x32_bf16 v[84:87], v[164:167], v[156:159], v[84:87]
    v_mfma_f32_16x16x32_bf16 v[84:87], v[160:163], v[152:155], v[84:87]
    s_waitcnt lgkmcnt(2)
    v_mfma_f32_16x16x32_bf16 v[88:91], v[160:163], v[192:195], v[88:91]
    v_mfma_f32_16x16x32_bf16 v[88:91], v[164:167], v[196:199], v[88:91]
    s_waitcnt lgkmcnt(0)
    v_mfma_f32_16x16x32_bf16 v[92:95], v[164:167], v[204:207], v[92:95]
    v_mfma_f32_16x16x32_bf16 v[92:95], v[160:163], v[200:203], v[92:95]
    v_cvt_pk_bf16_f32 v232, v64, v68
    v_cvt_pk_bf16_f32 v233, v72, v76
    v_mfma_f32_16x16x32_bf16 v[124:127], v[168:171], v[200:203], v[124:127]
    v_mfma_f32_16x16x32_bf16 v[124:127], v[172:175], v[204:207], v[124:127]
    v_cvt_pk_bf16_f32 v234, v80, v84
    v_mfma_f32_16x16x32_bf16 v[120:123], v[172:175], v[196:199], v[120:123]
    v_mfma_f32_16x16x32_bf16 v[120:123], v[168:171], v[192:195], v[120:123]
    v_mfma_f32_16x16x32_bf16 v[116:119], v[168:171], v[152:155], v[116:119]
    v_cvt_pk_bf16_f32 v235, v88, v92
    s_mov_b32 s35, 229376
    v_mfma_f32_16x16x32_bf16 v[116:119], v[172:175], v[156:159], v[116:119]
    buffer_store_dwordx4 v[232:235], v230, s[20:23], s35 offen sc1
    v_cvt_pk_bf16_f32 v236, v65, v69
    v_mfma_f32_16x16x32_bf16 v[112:115], v[172:175], v[148:151], v[112:115]
    v_cvt_pk_bf16_f32 v237, v73, v77
    v_cvt_pk_bf16_f32 v238, v81, v85
    v_mfma_f32_16x16x32_bf16 v[112:115], v[168:171], v[144:147], v[112:115]
    v_cvt_pk_bf16_f32 v239, v89, v93
    s_mov_b32 s35, 236544
    v_mfma_f32_16x16x32_bf16 v[108:111], v[168:171], v[216:219], v[108:111]
    buffer_store_dwordx4 v[236:239], v230, s[20:23], s35 offen sc1
    v_cvt_pk_bf16_f32 v240, v66, v70
    v_mfma_f32_16x16x32_bf16 v[108:111], v[172:175], v[220:223], v[108:111]
    v_cvt_pk_bf16_f32 v241, v74, v78
    v_cvt_pk_bf16_f32 v242, v82, v86
    v_mfma_f32_16x16x32_bf16 v[104:107], v[172:175], v[212:215], v[104:107]
    v_cvt_pk_bf16_f32 v243, v90, v94
    s_mov_b32 s35, 243712
    v_mfma_f32_16x16x32_bf16 v[104:107], v[168:171], v[208:211], v[104:107]
    buffer_store_dwordx4 v[240:243], v230, s[20:23], s35 offen sc1
    v_cvt_pk_bf16_f32 v244, v67, v71
    v_mfma_f32_16x16x32_bf16 v[100:103], v[168:171], v[184:187], v[100:103]
    v_cvt_pk_bf16_f32 v245, v75, v79
    v_cvt_pk_bf16_f32 v246, v83, v87
    v_mfma_f32_16x16x32_bf16 v[100:103], v[172:175], v[188:191], v[100:103]
    v_cvt_pk_bf16_f32 v247, v91, v95
    s_mov_b32 s35, 250880
    v_mfma_f32_16x16x32_bf16 v[96:99], v[172:175], v[180:183], v[96:99]
    buffer_store_dwordx4 v[244:247], v230, s[20:23], s35 offen sc1
    v_mfma_f32_16x16x32_bf16 v[96:99], v[168:171], v[176:179], v[96:99]
    s_nop 0
    s_nop 0
    s_nop 0
    s_nop 0
    s_nop 0
    s_nop 0
    s_nop 0
    s_nop 0
    v_cvt_pk_bf16_f32 v232, v96, v100
    v_cvt_pk_bf16_f32 v233, v104, v108
    v_cvt_pk_bf16_f32 v234, v112, v116
    v_cvt_pk_bf16_f32 v235, v120, v124
    s_mov_b32 s35, 344064
    buffer_store_dwordx4 v[232:235], v230, s[20:23], s35 offen sc1
    v_cvt_pk_bf16_f32 v236, v97, v101
    v_cvt_pk_bf16_f32 v237, v105, v109
    v_cvt_pk_bf16_f32 v238, v113, v117
    v_cvt_pk_bf16_f32 v239, v121, v125
    s_mov_b32 s35, 351232
    buffer_store_dwordx4 v[236:239], v230, s[20:23], s35 offen sc1
    v_cvt_pk_bf16_f32 v240, v98, v102
    v_cvt_pk_bf16_f32 v241, v106, v110
    v_cvt_pk_bf16_f32 v242, v114, v118
    v_cvt_pk_bf16_f32 v243, v122, v126
    s_mov_b32 s35, 358400
    buffer_store_dwordx4 v[240:243], v230, s[20:23], s35 offen sc1
    v_cvt_pk_bf16_f32 v244, v99, v103
    v_cvt_pk_bf16_f32 v245, v107, v111
    v_cvt_pk_bf16_f32 v246, v115, v119
    v_cvt_pk_bf16_f32 v247, v123, v127
    s_mov_b32 s35, 365568
    buffer_store_dwordx4 v[244:247], v230, s[20:23], s35 offen sc1
L_end:
    s_endpgm
.section .rodata,"a"
.p2align 6
.amdhsa_kernel standalone__w4a16_gemm_dequant__prompt_kernel
  .amdhsa_next_free_vgpr 256
  .amdhsa_next_free_sgpr 102
  .amdhsa_accum_offset 256
  .amdhsa_group_segment_fixed_size 0
  .amdhsa_kernarg_size 56
  .amdhsa_user_sgpr_count 2
  .amdhsa_user_sgpr_kernarg_segment_ptr 1
  .amdhsa_system_sgpr_workgroup_id_x 1
  .amdhsa_float_denorm_mode_16_64 3
.end_amdhsa_kernel
```
